```python
import torch

def _softmax(x, axis=-1):
    return torch.softmax(x, dim=axis)
def _gelu(x):
    return torch.nn.functional.gelu(x, approximate="tanh")
def _silu(x):
    return torch.nn.functional.silu(x)
def _sigmoid(x):
    return torch.sigmoid(x)
def _layernorm(x, axis=-1, eps=1e-5):
    m = x.mean(dim=axis, keepdim=True)
    v = x.var(dim=axis, keepdim=True, unbiased=False)
    return (x - m) / torch.sqrt(v + eps)
def _scatter_add(tgt, idx, src, axis=0):
    return tgt.clone().index_add_(axis, idx, src)
def _segment_sum(src, seg, n):
    out = torch.zeros((n,) + src.shape[1:], dtype=src.dtype)
    return out.index_add_(0, seg, src)
def _pad(x, pw):
    flat = tuple(v for pair in reversed(pw) for v in pair)
    return torch.nn.functional.pad(x, flat)

kernel_name = 'standalone__qk_norm__prompt'

def setup_inputs():

    _w = (lambda a: (lambda t: t.to(torch.bfloat16) if t.is_floating_point() else t)(torch.as_tensor(a)))
    B, H, S, D = 1, 32, 2048, 1024
    Dh = D // H
    return {
        "q": _w((lambda *s: torch.randn(*s, dtype=torch.bfloat16) * 0.05)(B, H, S, Dh)),
        "k": _w((lambda *s: torch.randn(*s, dtype=torch.bfloat16) * 0.05)(B, H, S, Dh)),
        "v": _w((lambda *s: torch.randn(*s, dtype=torch.bfloat16) * 0.8)(B, H, S, Dh)),
        "t": _w(torch.abs((lambda *s: torch.randn(*s, dtype=torch.bfloat16) * 0.8)(H)) + 1.0),
    }

def reference(q, k, v, t):
    eps = 1e-6
    qn = q / (torch.sqrt((q * q).sum(axis=-1, keepdims=True)) + eps)
    kn = k / (torch.sqrt((k * k).sum(axis=-1, keepdims=True)) + eps)
    logits = torch.einsum('bhqd,bhkd->bhqk', qn, kn) * t[None, :, None, None]
    attn = _softmax(logits, axis=-1)
    return torch.einsum('bhqk,bhkd->bhqd', attn, v)
```

```asm
; @launch grid=(256,1,1) block=(768,1,1) lds=148480
.amdgcn_target "amdgcn-amd-amdhsa--gfx950"
.text
.globl standalone__qk_norm__prompt_kernel
.p2align 8
.type standalone__qk_norm__prompt_kernel,@function
standalone__qk_norm__prompt_kernel:
    s_load_dwordx2 s[16:17], s[0:1], 0
    s_load_dwordx2 s[20:21], s[0:1], 8
    s_load_dwordx2 s[24:25], s[0:1], 16
    s_load_dwordx2 s[10:11], s[0:1], 24
    s_load_dwordx2 s[28:29], s[0:1], 32
    s_load_dwordx2 s[12:13], s[0:1], 48
    s_cmp_ge_u32 s2, 256
    s_cbranch_scc1 L_end
    v_lshrrev_b32 v3, 6, v0
    v_and_b32 v1, 63, v0
    v_readfirstlane_b32 s34, v3
    s_and_b32 s3, s2, 7
    s_lshl_b32 s3, s3, 2
    s_bfe_u32 s40, s2, 0x20003
    s_add_u32 s3, s3, s40
    s_lshl_b32 s32, s3, 17
    s_lshr_b32 s33, s2, 5
    v_lshlrev_b32 v2, 4, v1
    s_mov_b32 s18, 0x400000
    s_mov_b32 s19, 0x00020000
    s_mov_b64 s[22:23], s[18:19]
    s_mov_b64 s[26:27], s[18:19]
    s_mov_b64 s[30:31], s[18:19]
    s_mov_b32 s14, 0x804000
    s_mov_b32 s15, 0x00020000
    s_cmp_ge_u32 s34, 4
    s_cbranch_scc1 L_consumer
    s_setprio 3
    s_lshl_b32 s42, s34, 12
    s_add_u32 s32, s32, s42
    s_and_b32 s6, s3, 7
    s_lshl_b32 s6, s6, 14
    s_add_u32 s7, s32, s6
    s_add_u32 s44, s42, 16384
    v_lshlrev_b32 v20, 6, v1
    s_mov_b32 m0, s44
    s_add_u32 s41, s6, 16384
    s_and_b32 s41, s41, 0x1ffff
    s_add_u32 s41, s41, s32
    s_add_u32 s50, s33, 2
    s_lshl_b32 s50, s50, 14
    s_add_u32 s50, s50, s6
    s_and_b32 s50, s50, 0x1ffff
    s_add_u32 s50, s50, s32
    s_cmp_lt_u32 s33, 2
    s_cselect_b32 s40, s50, s41
    s_waitcnt lgkmcnt(0)
    buffer_load_dwordx4 v[32:35], v20, s[20:23], s7 offen offset:0
    buffer_load_dwordx4 v[36:39], v20, s[20:23], s7 offen offset:16
    buffer_load_dwordx4 v[40:43], v20, s[20:23], s7 offen offset:32
    buffer_load_dwordx4 v[44:47], v20, s[20:23], s7 offen offset:48
    buffer_load_dwordx4 v[48:51], v20, s[20:23], s40 offen offset:0
    buffer_load_dwordx4 v[52:55], v20, s[20:23], s40 offen offset:16
    buffer_load_dwordx4 v[56:59], v20, s[20:23], s40 offen offset:32
    buffer_load_dwordx4 v[60:63], v20, s[20:23], s40 offen offset:48
    s_branch L_producer
L_consumer:
    s_sub_u32 s34, s34, 4
    s_lshl_b32 s42, s34, 11
    s_lshl_b32 s40, s33, 14
    s_add_u32 s45, s32, s40
    s_add_u32 s45, s45, s42
    s_lshr_b32 s41, s3, 1
    s_lshl_b32 s41, s41, 2
    s_waitcnt lgkmcnt(0)
    buffer_load_dwordx4 v[68:71], v2, s[16:19], s45 offen nt
    buffer_load_dwordx4 v[72:75], v2, s[16:19], s45 offen offset:1024 nt
    s_load_dword s36, s[10:11], s41
    v_bfe_u32 v3, v1, 2, 1
    v_lshrrev_b32 v4, 5, v1
    v_cmp_eq_u32 vcc, v3, v4
    v_and_b32 v3, 1, v1
    v_lshlrev_b32 v3, 4, v3
    v_mov_b32 v4, 0x3f80
    v_lshlrev_b32 v4, v3, v4
    v_cndmask_b32 v4, 0, v4, vcc
    v_bfe_u32 v3, v1, 1, 1
    v_bfe_u32 v6, v1, 3, 2
    v_lshl_add_u32 v3, v6, 1, v3
    v_cmp_eq_u32 vcc, 0, v3
    s_nop 1
    v_cndmask_b32 v12, 0, v4, vcc
    v_cmp_eq_u32 vcc, 1, v3
    s_nop 1
    v_cndmask_b32 v13, 0, v4, vcc
    v_cmp_eq_u32 vcc, 2, v3
    s_nop 1
    v_cndmask_b32 v14, 0, v4, vcc
    v_cmp_eq_u32 vcc, 3, v3
    s_nop 1
    v_cndmask_b32 v15, 0, v4, vcc
    v_cmp_eq_u32 vcc, 4, v3
    s_nop 1
    v_cndmask_b32 v16, 0, v4, vcc
    v_cmp_eq_u32 vcc, 5, v3
    s_nop 1
    v_cndmask_b32 v17, 0, v4, vcc
    v_cmp_eq_u32 vcc, 6, v3
    s_nop 1
    v_cndmask_b32 v18, 0, v4, vcc
    v_cmp_eq_u32 vcc, 7, v3
    s_nop 1
    v_cndmask_b32 v19, 0, v4, vcc
    s_and_b32 s40, s34, 4
    s_lshl_b32 s40, s40, 11
    v_add_u32 v22, s40, v2
    v_lshrrev_b32 v3, 5, v1
    v_lshlrev_b32 v3, 9, v3
    v_bfe_u32 v4, v1, 2, 2
    v_lshl_add_u32 v3, v4, 6, v3
    v_bfe_u32 v4, v1, 4, 1
    v_lshl_add_u32 v3, v4, 5, v3
    v_and_b32 v4, 3, v1
    v_lshl_add_u32 v3, v4, 3, v3
    s_add_u32 s40, s40, 16384
    v_add_u32 v23, s40, v3
    v_mov_b32 v20, v22
    v_mov_b32 v21, v23
    v_mov_b32 v24, 0xdddddddd
    s_mul_i32 s40, s34, 2176
    s_add_u32 s40, s40, 131072
    v_mul_u32_u24 v3, 544, v4
    v_lshrrev_b32 v4, 2, v1
    v_lshl_add_u32 v3, v4, 4, v3
    v_add_u32 v29, s40, v3
    v_lshrrev_b32 v4, 5, v1
    v_lshl_add_u32 v3, v4, 5, v2
    v_add_u32 v28, s40, v3
    s_xor_b32 s41, s34, 4
    s_mul_i32 s41, s41, 2176
    s_add_u32 s41, s41, 131072
    v_add_u32 v5, s41, v3
    v_and_b32 v3, 15, v1
    v_mov_b32 v4, 0x3f803f80
    v_cmp_eq_u32 vcc, 0, v3
    s_nop 1
    v_cndmask_b32 v32, 0, v4, vcc
    v_cmp_eq_u32 vcc, 4, v3
    v_mov_b32 v33, v32
    s_nop 0
    v_cndmask_b32 v34, 0, v4, vcc
    v_mov_b32 v35, v34
    s_lshl_b32 s40, s34, 13
    v_add_u32 v31, s40, v2
    v_xor_b32 v26, 0x8000, v31
    v_and_b32 v3, 31, v1
    v_lshlrev_b32 v3, 6, v3
    v_lshrrev_b32 v4, 5, v1
    v_lshl_add_u32 v27, v4, 4, v3
    v_and_b32 v3, 15, v1
    v_lshlrev_b32 v3, 6, v3
    v_lshl_add_u32 v3, v4, 4, v3
    v_bfe_u32 v4, v1, 4, 1
    v_lshl_add_u32 v30, v4, 5, v3
    v_mov_b64 v[100:101], 0
    v_mov_b64 v[102:103], 0
    v_mov_b64 v[104:105], 0
    v_mov_b64 v[106:107], 0
    v_mov_b64 v[108:109], 0
    v_mov_b64 v[110:111], 0
    v_mov_b64 v[112:113], 0
    v_mov_b64 v[114:115], 0
    v_mov_b64 v[116:117], 0
    v_mov_b64 v[118:119], 0
    v_mov_b64 v[120:121], 0
    v_mov_b64 v[122:123], 0
    v_mov_b64 v[124:125], 0
    v_mov_b64 v[126:127], 0
    v_mov_b64 v[128:129], 0
    v_mov_b64 v[130:131], 0
    v_mov_b64 v[60:61], 0
    v_mov_b64 v[62:63], 0
    v_mov_b64 v[64:65], 0
    v_mov_b64 v[66:67], 0
    v_mov_b64 v[56:57], 0
    v_mov_b64 v[58:59], 0
    s_waitcnt lgkmcnt(0)
    s_lshl_b32 s40, s36, 16
    s_and_b32 s41, s36, 0xffff0000
    s_bitcmp1_b32 s3, 0
    s_cselect_b32 s36, s41, s40
    v_mov_b32 v25, 0x3fb8aa3b
    v_mul_f32 v25, s36, v25
    v_or_b32 v132, 0x80000000, v25
    v_mov_b32 v133, v132
    v_mov_b64 v[134:135], v[132:133]
    v_mov_b64 v[136:137], v[132:133]
    v_mov_b64 v[138:139], v[132:133]
    v_mov_b64 v[140:141], v[132:133]
    v_mov_b64 v[142:143], v[132:133]
    v_mov_b64 v[144:145], v[132:133]
    v_mov_b64 v[146:147], v[132:133]
    v_mov_b64 v[148:149], v[132:133]
    v_mov_b64 v[150:151], v[132:133]
    v_mov_b64 v[152:153], v[132:133]
    v_mov_b64 v[154:155], v[132:133]
    v_mov_b64 v[156:157], v[132:133]
    v_mov_b64 v[158:159], v[132:133]
    v_mov_b64 v[160:161], v[132:133]
    v_mov_b64 v[162:163], v[132:133]
    v_mov_b64 v[92:93], 0
    v_mov_b64 v[94:95], 0
    v_mov_b64 v[96:97], 0
    v_mov_b64 v[98:99], 0
    s_mov_b32 s35, 0
    s_mov_b32 s38, 32768
    s_and_b32 s36, s36, 0x7fffffff
    s_waitcnt vmcnt(0)
    v_dot2_f32_bf16 v3, v68, v68, 0
    v_dot2_f32_bf16 v4, v72, v72, 0
    v_dot2_f32_bf16 v3, v69, v69, v3
    v_dot2_f32_bf16 v4, v73, v73, v4
    v_dot2_f32_bf16 v3, v70, v70, v3
    v_dot2_f32_bf16 v4, v74, v74, v4
    v_dot2_f32_bf16 v3, v71, v71, v3
    v_dot2_f32_bf16 v4, v75, v75, v4
    v_mfma_f32_32x32x16_bf16 v[36:51], v[12:15], v[68:71], 0
    v_mfma_f32_32x32x16_bf16 v[36:51], v[16:19], v[72:75], v[36:51]
    s_nop 0
    v_add_f32_dpp v3, v3, v3 quad_perm:[1,0,3,2] row_mask:0xf bank_mask:0xf
    v_add_f32_dpp v4, v4, v4 quad_perm:[1,0,3,2] row_mask:0xf bank_mask:0xf
    s_nop 0
    v_add_f32_dpp v3, v3, v3 quad_perm:[2,3,0,1] row_mask:0xf bank_mask:0xf
    v_add_f32_dpp v4, v4, v4 quad_perm:[2,3,0,1] row_mask:0xf bank_mask:0xf
    v_sqrt_f32 v3, v3
    v_sqrt_f32 v4, v4
    v_add_f32 v3, 0x358637bd, v3
    v_add_f32 v4, 0x358637bd, v4
    v_rcp_f32 v3, v3
    v_rcp_f32 v4, v4
    v_mul_f32 v6, v3, v25
    v_mul_f32 v8, v4, v25
    v_pk_mul_f32 v[36:37], v[36:37], v[6:7] op_sel_hi:[1,0]
    v_pk_mul_f32 v[38:39], v[38:39], v[6:7] op_sel_hi:[1,0]
    v_pk_mul_f32 v[40:41], v[40:41], v[6:7] op_sel_hi:[1,0]
    v_pk_mul_f32 v[42:43], v[42:43], v[6:7] op_sel_hi:[1,0]
    v_cvt_pk_bf16_f32 v76, v36, v37
    v_cvt_pk_bf16_f32 v77, v38, v39
    v_cvt_pk_bf16_f32 v78, v40, v41
    v_cvt_pk_bf16_f32 v79, v42, v43
    ds_write_b128 v29, v[76:79]
    v_pk_mul_f32 v[44:45], v[44:45], v[8:9] op_sel_hi:[1,0]
    v_pk_mul_f32 v[46:47], v[46:47], v[8:9] op_sel_hi:[1,0]
    v_pk_mul_f32 v[48:49], v[48:49], v[8:9] op_sel_hi:[1,0]
    v_pk_mul_f32 v[50:51], v[50:51], v[8:9] op_sel_hi:[1,0]
    v_cvt_pk_bf16_f32 v80, v44, v45
    v_cvt_pk_bf16_f32 v81, v46, v47
    v_cvt_pk_bf16_f32 v82, v48, v49
    v_cvt_pk_bf16_f32 v83, v50, v51
    ds_write_b128 v29, v[80:83] offset:256
    s_cmp_le_u32 s36, 0x41800000
    s_waitcnt lgkmcnt(0)
    s_barrier
    ds_read_b128 v[36:39], v5
    ds_read_b128 v[40:43], v5 offset:1088
    s_cbranch_scc0 L_maxpass
L_start:
    ds_read_b128 v[12:15], v20 offset:0
    ds_read_b128 v[16:19], v20 offset:1024
    ds_read_b128 v[44:47], v28
    ds_read_b128 v[48:51], v28 offset:1088
    ds_read_b64_tr_b16 v[52:53], v21 offset:0
    ds_read_b64_tr_b16 v[54:55], v21 offset:256
    s_waitcnt lgkmcnt(4)
    v_mfma_f32_32x32x16_bf16 v[68:83], v[12:15], v[36:39], v[132:147]
    v_mfma_f32_32x32x16_bf16 v[68:83], v[16:19], v[40:43], v[68:83]
    s_waitcnt lgkmcnt(2)
    s_nop 7
    s_nop 2
    .p2align 3
L_stage:
    s_setprio 2
    v_exp_f32 v68, v68
    v_exp_f32 v69, v69
    v_smfmac_f32_32x32x32_bf16 v[116:131], v[56:59], v[92:99], v24
    v_exp_f32 v70, v70
    v_exp_f32 v71, v71
    v_exp_f32 v72, v72
    v_smfmac_f32_16x16x64_bf16 v[64:67], v[32:35], v[92:99], v24
    ds_read_b64_tr_b16 v[56:57], v21 offset:1024
    ds_read_b64_tr_b16 v[58:59], v21 offset:1280
    v_exp_f32 v73, v73
    v_mfma_f32_32x32x16_bf16 v[84:99], v[12:15], v[44:47], v[148:163]
    v_exp_f32 v74, v74
    v_exp_f32 v75, v75
    v_exp_f32 v76, v76
    v_mfma_f32_32x32x16_bf16 v[84:99], v[16:19], v[48:51], v[84:99]
    ds_read_b128 v[12:15], v20 offset:2048
    ds_read_b128 v[16:19], v20 offset:3072
    v_exp_f32 v77, v77
    v_exp_f32 v78, v78
    v_exp_f32 v79, v79
    s_waitcnt lgkmcnt(4)
    v_smfmac_f32_32x32x32_bf16 v[100:115], v[52:55], v[68:75], v24
    v_exp_f32 v80, v80
    v_exp_f32 v81, v81
    v_exp_f32 v82, v82
    v_smfmac_f32_16x16x64_bf16 v[60:63], v[32:35], v[68:75], v24
    v_exp_f32 v83, v83
    v_exp_f32 v84, v84
    v_exp_f32 v85, v85
    s_waitcnt lgkmcnt(2)
    v_smfmac_f32_32x32x32_bf16 v[100:115], v[56:59], v[76:83], v24
    v_exp_f32 v86, v86
    v_exp_f32 v87, v87
    v_exp_f32 v88, v88
    v_smfmac_f32_16x16x64_bf16 v[60:63], v[32:35], v[76:83], v24
    v_exp_f32 v89, v89
    s_waitcnt lgkmcnt(0)
    v_mfma_f32_32x32x16_bf16 v[68:83], v[12:15], v[36:39], v[132:147]
    v_exp_f32 v90, v90
    v_exp_f32 v91, v91
    v_exp_f32 v92, v92
    v_mfma_f32_32x32x16_bf16 v[68:83], v[16:19], v[40:43], v[68:83]
    v_exp_f32 v93, v93
    v_exp_f32 v94, v94
    v_exp_f32 v95, v95
    v_smfmac_f32_32x32x32_bf16 v[116:131], v[52:55], v[84:91], v24
    ds_read_b64_tr_b16 v[52:53], v21 offset:2048
    ds_read_b64_tr_b16 v[54:55], v21 offset:2304
    v_exp_f32 v96, v96
    v_exp_f32 v97, v97
    v_exp_f32 v98, v98
    v_smfmac_f32_16x16x64_bf16 v[64:67], v[32:35], v[84:91], v24
    v_exp_f32 v99, v99
    s_setprio 1
    v_exp_f32 v68, v68
    v_exp_f32 v69, v69
    v_smfmac_f32_32x32x32_bf16 v[116:131], v[56:59], v[92:99], v24
    v_exp_f32 v70, v70
    v_exp_f32 v71, v71
    v_exp_f32 v72, v72
    v_smfmac_f32_16x16x64_bf16 v[64:67], v[32:35], v[92:99], v24
    ds_read_b64_tr_b16 v[56:57], v21 offset:3072
    ds_read_b64_tr_b16 v[58:59], v21 offset:3328
    v_exp_f32 v73, v73
    v_mfma_f32_32x32x16_bf16 v[84:99], v[12:15], v[44:47], v[148:163]
    v_exp_f32 v74, v74
    v_exp_f32 v75, v75
    v_exp_f32 v76, v76
    v_mfma_f32_32x32x16_bf16 v[84:99], v[16:19], v[48:51], v[84:99]
    ds_read_b128 v[12:15], v20 offset:4096
    ds_read_b128 v[16:19], v20 offset:5120
    v_exp_f32 v77, v77
    v_exp_f32 v78, v78
    v_exp_f32 v79, v79
    s_waitcnt lgkmcnt(4)
    v_smfmac_f32_32x32x32_bf16 v[100:115], v[52:55], v[68:75], v24
    v_exp_f32 v80, v80
    v_exp_f32 v81, v81
    v_exp_f32 v82, v82
    v_smfmac_f32_16x16x64_bf16 v[60:63], v[32:35], v[68:75], v24
    v_exp_f32 v83, v83
    v_exp_f32 v84, v84
    v_exp_f32 v85, v85
    s_waitcnt lgkmcnt(2)
    v_smfmac_f32_32x32x32_bf16 v[100:115], v[56:59], v[76:83], v24
    v_exp_f32 v86, v86
    v_exp_f32 v87, v87
    v_exp_f32 v88, v88
    v_smfmac_f32_16x16x64_bf16 v[60:63], v[32:35], v[76:83], v24
    v_exp_f32 v89, v89
    s_waitcnt lgkmcnt(0)
    v_mfma_f32_32x32x16_bf16 v[68:83], v[12:15], v[36:39], v[132:147]
    v_exp_f32 v90, v90
    v_exp_f32 v91, v91
    v_exp_f32 v92, v92
    v_mfma_f32_32x32x16_bf16 v[68:83], v[16:19], v[40:43], v[68:83]
    v_exp_f32 v93, v93
    v_exp_f32 v94, v94
    v_exp_f32 v95, v95
    v_smfmac_f32_32x32x32_bf16 v[116:131], v[52:55], v[84:91], v24
    ds_read_b64_tr_b16 v[52:53], v21 offset:4096
    ds_read_b64_tr_b16 v[54:55], v21 offset:4352
    v_exp_f32 v96, v96
    v_exp_f32 v97, v97
    v_exp_f32 v98, v98
    v_smfmac_f32_16x16x64_bf16 v[64:67], v[32:35], v[84:91], v24
    v_exp_f32 v99, v99
    s_setprio 0
    v_exp_f32 v68, v68
    v_exp_f32 v69, v69
    v_smfmac_f32_32x32x32_bf16 v[116:131], v[56:59], v[92:99], v24
    v_exp_f32 v70, v70
    v_exp_f32 v71, v71
    v_exp_f32 v72, v72
    v_smfmac_f32_16x16x64_bf16 v[64:67], v[32:35], v[92:99], v24
    ds_read_b64_tr_b16 v[56:57], v21 offset:5120
    ds_read_b64_tr_b16 v[58:59], v21 offset:5376
    v_exp_f32 v73, v73
    v_mfma_f32_32x32x16_bf16 v[84:99], v[12:15], v[44:47], v[148:163]
    v_exp_f32 v74, v74
    v_exp_f32 v75, v75
    v_exp_f32 v76, v76
    v_mfma_f32_32x32x16_bf16 v[84:99], v[16:19], v[48:51], v[84:99]
    ds_read_b128 v[12:15], v20 offset:6144
    ds_read_b128 v[16:19], v20 offset:7168
    v_exp_f32 v77, v77
    v_exp_f32 v78, v78
    v_exp_f32 v79, v79
    s_waitcnt lgkmcnt(4)
    v_smfmac_f32_32x32x32_bf16 v[100:115], v[52:55], v[68:75], v24
    v_exp_f32 v80, v80
    v_exp_f32 v81, v81
    v_exp_f32 v82, v82
    v_smfmac_f32_16x16x64_bf16 v[60:63], v[32:35], v[68:75], v24
    v_exp_f32 v83, v83
    v_exp_f32 v84, v84
    v_exp_f32 v85, v85
    s_waitcnt lgkmcnt(2)
    v_smfmac_f32_32x32x32_bf16 v[100:115], v[56:59], v[76:83], v24
    v_exp_f32 v86, v86
    v_exp_f32 v87, v87
    v_exp_f32 v88, v88
    v_smfmac_f32_16x16x64_bf16 v[60:63], v[32:35], v[76:83], v24
    v_exp_f32 v89, v89
    s_waitcnt lgkmcnt(0)
    v_mfma_f32_32x32x16_bf16 v[68:83], v[12:15], v[36:39], v[132:147]
    v_exp_f32 v90, v90
    v_exp_f32 v91, v91
    v_exp_f32 v92, v92
    v_mfma_f32_32x32x16_bf16 v[68:83], v[16:19], v[40:43], v[68:83]
    v_exp_f32 v93, v93
    v_exp_f32 v94, v94
    v_exp_f32 v95, v95
    v_smfmac_f32_32x32x32_bf16 v[116:131], v[52:55], v[84:91], v24
    ds_read_b64_tr_b16 v[52:53], v21 offset:6144
    ds_read_b64_tr_b16 v[54:55], v21 offset:6400
    v_exp_f32 v96, v96
    v_exp_f32 v97, v97
    v_exp_f32 v98, v98
    v_smfmac_f32_16x16x64_bf16 v[64:67], v[32:35], v[84:91], v24
    v_exp_f32 v99, v99
    s_cmp_eq_u32 s35, 7
    s_barrier
    s_setprio 3
    v_exp_f32 v68, v68
    v_exp_f32 v69, v69
    v_smfmac_f32_32x32x32_bf16 v[116:131], v[56:59], v[92:99], v24
    v_exp_f32 v70, v70
    v_exp_f32 v71, v71
    v_exp_f32 v72, v72
    v_smfmac_f32_16x16x64_bf16 v[64:67], v[32:35], v[92:99], v24
    ds_read_b64_tr_b16 v[56:57], v21 offset:7168
    ds_read_b64_tr_b16 v[58:59], v21 offset:7424
    v_exp_f32 v73, v73
    v_mfma_f32_32x32x16_bf16 v[84:99], v[12:15], v[44:47], v[148:163]
    v_exp_f32 v74, v74
    v_exp_f32 v75, v75
    v_exp_f32 v76, v76
    v_mfma_f32_32x32x16_bf16 v[84:99], v[16:19], v[48:51], v[84:99]
    v_add_u32 v20, s38, v22
    ds_read_b128 v[12:15], v20 offset:0
    ds_read_b128 v[16:19], v20 offset:1024
    v_exp_f32 v77, v77
    v_exp_f32 v78, v78
    v_exp_f32 v79, v79
    s_waitcnt lgkmcnt(4)
    v_smfmac_f32_32x32x32_bf16 v[100:115], v[52:55], v[68:75], v24
    v_exp_f32 v80, v80
    v_exp_f32 v81, v81
    v_exp_f32 v82, v82
    v_smfmac_f32_16x16x64_bf16 v[60:63], v[32:35], v[68:75], v24
    v_exp_f32 v83, v83
    s_cbranch_scc1 L_last
    v_exp_f32 v84, v84
    v_exp_f32 v85, v85
    s_waitcnt lgkmcnt(2)
    v_smfmac_f32_32x32x32_bf16 v[100:115], v[56:59], v[76:83], v24
    v_exp_f32 v86, v86
    v_exp_f32 v87, v87
    v_exp_f32 v88, v88
    v_smfmac_f32_16x16x64_bf16 v[60:63], v[32:35], v[76:83], v24
    v_exp_f32 v89, v89
    s_waitcnt lgkmcnt(0)
    v_mfma_f32_32x32x16_bf16 v[68:83], v[12:15], v[36:39], v[132:147]
    v_exp_f32 v90, v90
    v_exp_f32 v91, v91
    v_exp_f32 v92, v92
    v_mfma_f32_32x32x16_bf16 v[68:83], v[16:19], v[40:43], v[68:83]
    v_add_u32 v21, s38, v23
    v_exp_f32 v93, v93
    v_exp_f32 v94, v94
    v_exp_f32 v95, v95
    v_smfmac_f32_32x32x32_bf16 v[116:131], v[52:55], v[84:91], v24
    ds_read_b64_tr_b16 v[52:53], v21 offset:0
    ds_read_b64_tr_b16 v[54:55], v21 offset:256
    v_exp_f32 v96, v96
    v_exp_f32 v97, v97
    v_exp_f32 v98, v98
    v_smfmac_f32_16x16x64_bf16 v[64:67], v[32:35], v[84:91], v24
    v_exp_f32 v99, v99
    s_add_u32 s35, s35, 1
    s_add_u32 s38, s38, 32768
    s_and_b32 s38, s38, 0x1ffff
    s_branch L_stage
L_last:
    s_setprio 0
    s_lshl_b32 s40, s34, 13
    v_lshl_add_u32 v22, v1, 2, s40
    v_xor_b32 v23, 0x8000, v22
    v_exp_f32 v84, v84
    v_exp_f32 v85, v85
    s_waitcnt lgkmcnt(2)
    v_smfmac_f32_32x32x32_bf16 v[100:115], v[56:59], v[76:83], v24
    v_exp_f32 v86, v86
    v_exp_f32 v87, v87
    v_exp_f32 v88, v88
    v_smfmac_f32_16x16x64_bf16 v[60:63], v[32:35], v[76:83], v24
    v_exp_f32 v89, v89
    v_exp_f32 v90, v90
    v_exp_f32 v91, v91
    v_exp_f32 v92, v92
    v_exp_f32 v93, v93
    v_smfmac_f32_32x32x32_bf16 v[116:131], v[52:55], v[84:91], v24
    v_exp_f32 v94, v94
    v_exp_f32 v95, v95
    ds_write_b128 v26, v[100:103] offset:0
    ds_write_b128 v26, v[104:107] offset:1024
    ds_write_b128 v26, v[108:111] offset:2048
    ds_write_b128 v26, v[112:115] offset:3072
    ds_write_b32 v23, v60 offset:4096
    v_exp_f32 v96, v96
    v_smfmac_f32_16x16x64_bf16 v[64:67], v[32:35], v[84:91], v24
    v_exp_f32 v97, v97
    v_exp_f32 v98, v98
    v_exp_f32 v99, v99
    s_nop 0
    s_waitcnt lgkmcnt(0)
    v_smfmac_f32_32x32x32_bf16 v[116:131], v[56:59], v[92:99], v24
    v_smfmac_f32_16x16x64_bf16 v[64:67], v[32:35], v[92:99], v24
    s_barrier
    ds_read_b32 v60, v22 offset:4096
    ds_read_b128 v[100:103], v31 offset:0
    ds_read_b128 v[104:107], v31 offset:1024
    ds_read_b128 v[108:111], v31 offset:2048
    ds_read_b128 v[112:115], v31 offset:3072
    s_nop 3
    s_waitcnt lgkmcnt(4)
    v_add_f32 v60, v60, v64
    v_rcp_f32 v6, v60
    s_nop 0
    v_mov_b32 v4, v6
    s_waitcnt lgkmcnt(3)
    v_pk_add_f32 v[100:101], v[100:101], v[116:117]
    v_pk_add_f32 v[102:103], v[102:103], v[118:119]
    v_permlane32_swap_b32 v6, v4
    s_waitcnt lgkmcnt(2)
    v_pk_add_f32 v[104:105], v[104:105], v[120:121]
    v_pk_add_f32 v[106:107], v[106:107], v[122:123]
    s_waitcnt lgkmcnt(1)
    v_pk_add_f32 v[108:109], v[108:109], v[124:125]
    v_pk_add_f32 v[110:111], v[110:111], v[126:127]
    s_waitcnt lgkmcnt(0)
    v_pk_add_f32 v[112:113], v[112:113], v[128:129]
    v_pk_add_f32 v[114:115], v[114:115], v[130:131]
    v_pk_mul_f32 v[100:101], v[100:101], v[6:7] op_sel_hi:[1,0]
    v_pk_mul_f32 v[102:103], v[102:103], v[6:7] op_sel_hi:[1,0]
    v_pk_mul_f32 v[104:105], v[104:105], v[6:7] op_sel_hi:[1,0]
    v_pk_mul_f32 v[106:107], v[106:107], v[6:7] op_sel_hi:[1,0]
    v_pk_mul_f32 v[108:109], v[108:109], v[6:7] op_sel_hi:[1,0]
    v_pk_mul_f32 v[110:111], v[110:111], v[6:7] op_sel_hi:[1,0]
    v_pk_mul_f32 v[112:113], v[112:113], v[6:7] op_sel_hi:[1,0]
    v_pk_mul_f32 v[114:115], v[114:115], v[6:7] op_sel_hi:[1,0]
    v_cvt_pk_bf16_f32 v68, v100, v101
    v_cvt_pk_bf16_f32 v69, v102, v103
    v_cvt_pk_bf16_f32 v70, v104, v105
    v_cvt_pk_bf16_f32 v71, v106, v107
    v_cvt_pk_bf16_f32 v72, v108, v109
    v_cvt_pk_bf16_f32 v73, v110, v111
    v_permlane32_swap_b32 v68, v70
    v_permlane32_swap_b32 v69, v71
    v_cvt_pk_bf16_f32 v74, v112, v113
    v_cvt_pk_bf16_f32 v75, v114, v115
    s_nop 1
    v_permlane32_swap_b32 v72, v74
    v_permlane32_swap_b32 v73, v75
    s_nop 1
    v_permlane16_swap_b32 v68, v72
    v_permlane16_swap_b32 v69, v73
    v_permlane16_swap_b32 v70, v74
    v_permlane16_swap_b32 v71, v75
    s_nop 1
    buffer_store_dwordx4 v[68:71], v30, s[28:31], s45 offen nt sc1
    buffer_store_dwordx4 v[72:75], v30, s[28:31], s45 offen offset:1024 nt sc1
L_end:
    s_endpgm
L_producer:
    s_lshl_b32 s4, s3, 2
    s_add_u32 s4, s4, s34
    s_lshl_b32 s4, s4, 7
    s_add_u32 s4, s4, 8388608
    v_min_u32 v23, 17, v1
    v_lshlrev_b32 v23, 2, v23
    s_add_u32 s47, s32, 4194304
    v_bfe_u32 v3, v1, 2, 1
    v_lshrrev_b32 v4, 5, v1
    v_cmp_eq_u32 vcc, v3, v4
    v_and_b32 v3, 1, v1
    v_lshlrev_b32 v3, 4, v3
    v_mov_b32 v4, 0x3f80
    v_lshlrev_b32 v4, v3, v4
    v_cndmask_b32 v4, 0, v4, vcc
    v_bfe_u32 v3, v1, 1, 1
    v_bfe_u32 v6, v1, 3, 2
    v_lshl_add_u32 v3, v6, 1, v3
    v_cmp_eq_u32 vcc, 0, v3
    s_nop 1
    v_cndmask_b32 v12, 0, v4, vcc
    v_cmp_eq_u32 vcc, 1, v3
    s_nop 1
    v_cndmask_b32 v13, 0, v4, vcc
    v_cmp_eq_u32 vcc, 2, v3
    s_nop 1
    v_cndmask_b32 v14, 0, v4, vcc
    v_cmp_eq_u32 vcc, 3, v3
    s_nop 1
    v_cndmask_b32 v15, 0, v4, vcc
    v_cmp_eq_u32 vcc, 4, v3
    s_nop 1
    v_cndmask_b32 v16, 0, v4, vcc
    v_cmp_eq_u32 vcc, 5, v3
    s_nop 1
    v_cndmask_b32 v17, 0, v4, vcc
    v_cmp_eq_u32 vcc, 6, v3
    s_nop 1
    v_cndmask_b32 v18, 0, v4, vcc
    v_cmp_eq_u32 vcc, 7, v3
    s_nop 1
    v_cndmask_b32 v19, 0, v4, vcc
    v_and_b32 v3, 31, v1
    v_lshlrev_b32 v3, 4, v3
    v_lshrrev_b32 v4, 5, v1
    v_lshl_add_u32 v28, v4, 11, v3
    v_add_u32 v21, s42, v28
    s_mov_b32 s46, 0
    s_mov_b32 s49, 0
    s_mov_b32 s35, 0
    s_sub_u32 s48, s33, 2
    s_cmp_ge_u32 s33, 6
    s_cselect_b32 s48, 100, s48
    s_waitcnt vmcnt(4)
    buffer_load_dwordx4 v2, s[24:27], s7 offen offset:0 lds
    buffer_load_dwordx4 v2, s[24:27], s7 offen offset:1024 lds
    buffer_load_dwordx4 v2, s[24:27], s7 offen offset:2048 lds
    buffer_load_dwordx4 v2, s[24:27], s7 offen offset:3072 lds
    buffer_load_dword v24, v23, s[12:15], s4 offen sc1
    v_dot2_f32_bf16 v3, v32, v32, 0
    v_dot2_f32_bf16 v8, v36, v36, 0
    v_dot2_f32_bf16 v4, v40, v40, 0
    v_dot2_f32_bf16 v9, v44, v44, 0
    v_dot2_f32_bf16 v3, v33, v33, v3
    v_dot2_f32_bf16 v8, v37, v37, v8
    v_dot2_f32_bf16 v4, v41, v41, v4
    v_dot2_f32_bf16 v9, v45, v45, v9
    v_dot2_f32_bf16 v3, v34, v34, v3
    v_dot2_f32_bf16 v8, v38, v38, v8
    v_dot2_f32_bf16 v4, v42, v42, v4
    v_dot2_f32_bf16 v9, v46, v46, v9
    v_dot2_f32_bf16 v3, v35, v35, v3
    v_dot2_f32_bf16 v8, v39, v39, v8
    v_dot2_f32_bf16 v4, v43, v43, v4
    v_dot2_f32_bf16 v9, v47, v47, v9
    v_mfma_f32_32x32x16_bf16 v[80:95], v[12:15], v[32:35], 0
    v_mfma_f32_32x32x16_bf16 v[80:95], v[16:19], v[36:39], v[80:95]
    v_mfma_f32_32x32x16_bf16 v[96:111], v[12:15], v[40:43], 0
    v_mfma_f32_32x32x16_bf16 v[96:111], v[16:19], v[44:47], v[96:111]
    v_add_f32 v3, v3, v4
    v_add_f32 v8, v8, v9
    v_add_f32 v3, v3, v8
    v_sqrt_f32 v3, v3
    s_nop 0
    v_add_f32 v3, 0x358637bd, v3
    v_rcp_f32 v6, v3
    s_nop 5
    v_pk_mul_f32 v[80:81], v[80:81], v[6:7] op_sel_hi:[1,0]
    v_pk_mul_f32 v[82:83], v[82:83], v[6:7] op_sel_hi:[1,0]
    v_pk_mul_f32 v[84:85], v[84:85], v[6:7] op_sel_hi:[1,0]
    v_pk_mul_f32 v[86:87], v[86:87], v[6:7] op_sel_hi:[1,0]
    v_pk_mul_f32 v[88:89], v[88:89], v[6:7] op_sel_hi:[1,0]
    v_pk_mul_f32 v[90:91], v[90:91], v[6:7] op_sel_hi:[1,0]
    v_pk_mul_f32 v[92:93], v[92:93], v[6:7] op_sel_hi:[1,0]
    v_pk_mul_f32 v[94:95], v[94:95], v[6:7] op_sel_hi:[1,0]
    v_pk_mul_f32 v[96:97], v[96:97], v[6:7] op_sel_hi:[1,0]
    v_pk_mul_f32 v[98:99], v[98:99], v[6:7] op_sel_hi:[1,0]
    v_pk_mul_f32 v[100:101], v[100:101], v[6:7] op_sel_hi:[1,0]
    v_pk_mul_f32 v[102:103], v[102:103], v[6:7] op_sel_hi:[1,0]
    v_pk_mul_f32 v[104:105], v[104:105], v[6:7] op_sel_hi:[1,0]
    v_pk_mul_f32 v[106:107], v[106:107], v[6:7] op_sel_hi:[1,0]
    v_pk_mul_f32 v[108:109], v[108:109], v[6:7] op_sel_hi:[1,0]
    v_pk_mul_f32 v[110:111], v[110:111], v[6:7] op_sel_hi:[1,0]
    v_cvt_pk_bf16_f32 v112, v80, v81
    v_cvt_pk_bf16_f32 v113, v82, v83
    v_cvt_pk_bf16_f32 v114, v84, v85
    v_cvt_pk_bf16_f32 v115, v86, v87
    v_cvt_pk_bf16_f32 v116, v88, v89
    v_cvt_pk_bf16_f32 v117, v90, v91
    v_cvt_pk_bf16_f32 v118, v92, v93
    v_cvt_pk_bf16_f32 v119, v94, v95
    v_cvt_pk_bf16_f32 v120, v96, v97
    v_cvt_pk_bf16_f32 v121, v98, v99
    v_cvt_pk_bf16_f32 v122, v100, v101
    v_cvt_pk_bf16_f32 v123, v102, v103
    v_cvt_pk_bf16_f32 v124, v104, v105
    v_cvt_pk_bf16_f32 v125, v106, v107
    v_cvt_pk_bf16_f32 v126, v108, v109
    v_cvt_pk_bf16_f32 v127, v110, v111
    ds_write_b128 v21, v[112:115] offset:0
    ds_write_b128 v21, v[116:119] offset:512
    ds_write_b128 v21, v[120:123] offset:1024
    ds_write_b128 v21, v[124:127] offset:1536
    s_waitcnt vmcnt(5) lgkmcnt(0)
    v_dot2_f32_bf16 v3, v48, v48, 0
    v_dot2_f32_bf16 v8, v52, v52, 0
    v_dot2_f32_bf16 v4, v56, v56, 0
    v_dot2_f32_bf16 v9, v60, v60, 0
    v_dot2_f32_bf16 v3, v49, v49, v3
    v_dot2_f32_bf16 v8, v53, v53, v8
    v_dot2_f32_bf16 v4, v57, v57, v4
    v_dot2_f32_bf16 v9, v61, v61, v9
    v_dot2_f32_bf16 v3, v50, v50, v3
    v_dot2_f32_bf16 v8, v54, v54, v8
    v_dot2_f32_bf16 v4, v58, v58, v4
    v_dot2_f32_bf16 v9, v62, v62, v9
    v_dot2_f32_bf16 v3, v51, v51, v3
    v_dot2_f32_bf16 v8, v55, v55, v8
    v_dot2_f32_bf16 v4, v59, v59, v4
    v_dot2_f32_bf16 v9, v63, v63, v9
    v_mfma_f32_32x32x16_bf16 v[80:95], v[12:15], v[48:51], 0
    v_mfma_f32_32x32x16_bf16 v[80:95], v[16:19], v[52:55], v[80:95]
    v_mfma_f32_32x32x16_bf16 v[96:111], v[12:15], v[56:59], 0
    v_mfma_f32_32x32x16_bf16 v[96:111], v[16:19], v[60:63], v[96:111]
    v_add_f32 v3, v3, v4
    v_add_f32 v8, v8, v9
    v_add_f32 v3, v3, v8
    v_sqrt_f32 v3, v3
    s_nop 0
    v_add_f32 v3, 0x358637bd, v3
    v_rcp_f32 v6, v3
    s_nop 5
    v_pk_mul_f32 v[80:81], v[80:81], v[6:7] op_sel_hi:[1,0]
    v_pk_mul_f32 v[82:83], v[82:83], v[6:7] op_sel_hi:[1,0]
    v_pk_mul_f32 v[84:85], v[84:85], v[6:7] op_sel_hi:[1,0]
    v_pk_mul_f32 v[86:87], v[86:87], v[6:7] op_sel_hi:[1,0]
    v_pk_mul_f32 v[88:89], v[88:89], v[6:7] op_sel_hi:[1,0]
    v_pk_mul_f32 v[90:91], v[90:91], v[6:7] op_sel_hi:[1,0]
    v_pk_mul_f32 v[92:93], v[92:93], v[6:7] op_sel_hi:[1,0]
    v_pk_mul_f32 v[94:95], v[94:95], v[6:7] op_sel_hi:[1,0]
    v_pk_mul_f32 v[96:97], v[96:97], v[6:7] op_sel_hi:[1,0]
    v_pk_mul_f32 v[98:99], v[98:99], v[6:7] op_sel_hi:[1,0]
    v_pk_mul_f32 v[100:101], v[100:101], v[6:7] op_sel_hi:[1,0]
    v_pk_mul_f32 v[102:103], v[102:103], v[6:7] op_sel_hi:[1,0]
    v_pk_mul_f32 v[104:105], v[104:105], v[6:7] op_sel_hi:[1,0]
    v_pk_mul_f32 v[106:107], v[106:107], v[6:7] op_sel_hi:[1,0]
    v_pk_mul_f32 v[108:109], v[108:109], v[6:7] op_sel_hi:[1,0]
    v_pk_mul_f32 v[110:111], v[110:111], v[6:7] op_sel_hi:[1,0]
    v_cvt_pk_bf16_f32 v112, v80, v81
    v_cvt_pk_bf16_f32 v113, v82, v83
    v_cvt_pk_bf16_f32 v114, v84, v85
    v_cvt_pk_bf16_f32 v115, v86, v87
    v_cvt_pk_bf16_f32 v116, v88, v89
    v_cvt_pk_bf16_f32 v117, v90, v91
    v_cvt_pk_bf16_f32 v118, v92, v93
    v_cvt_pk_bf16_f32 v119, v94, v95
    v_cvt_pk_bf16_f32 v120, v96, v97
    v_cvt_pk_bf16_f32 v121, v98, v99
    v_cvt_pk_bf16_f32 v122, v100, v101
    v_cvt_pk_bf16_f32 v123, v102, v103
    v_cvt_pk_bf16_f32 v124, v104, v105
    v_cvt_pk_bf16_f32 v125, v106, v107
    v_cvt_pk_bf16_f32 v126, v108, v109
    v_cvt_pk_bf16_f32 v127, v110, v111
    s_cmp_ge_u32 s33, 2
    s_cbranch_scc1 L_k1
    s_lshl_b32 s40, s33, 14
    s_add_u32 s40, s40, s47
    buffer_store_dwordx4 v[112:115], v28, s[12:15], s40 offen offset:0 sc1
    buffer_store_dwordx4 v[116:119], v28, s[12:15], s40 offen offset:512 sc1
    buffer_store_dwordx4 v[120:123], v28, s[12:15], s40 offen offset:1024 sc1
    buffer_store_dwordx4 v[124:127], v28, s[12:15], s40 offen offset:1536 sc1
    buffer_load_dwordx4 v[32:35], v20, s[20:23], s41 offen offset:0
    buffer_load_dwordx4 v[36:39], v20, s[20:23], s41 offen offset:16
    buffer_load_dwordx4 v[40:43], v20, s[20:23], s41 offen offset:32
    buffer_load_dwordx4 v[44:47], v20, s[20:23], s41 offen offset:48
    s_waitcnt vmcnt(9)
    s_branch L_k1d
L_k1:
    ds_write_b128 v21, v[112:115] offset:32768
    ds_write_b128 v21, v[116:119] offset:33280
    ds_write_b128 v21, v[120:123] offset:33792
    ds_write_b128 v21, v[124:127] offset:34304
    s_waitcnt vmcnt(1) lgkmcnt(0)
L_k1d:
    s_barrier
    s_add_u32 m0, s44, 32768
    s_add_u32 s37, s35, 2
    s_lshl_b32 s37, s37, 14
    s_add_u32 s37, s37, s6
    s_and_b32 s37, s37, 0x1ffff
    s_add_u32 s37, s37, s32
    buffer_load_dwordx4 v2, s[24:27], s41 offen offset:0 lds
    buffer_load_dwordx4 v2, s[24:27], s41 offen offset:1024 lds
    buffer_load_dwordx4 v2, s[24:27], s41 offen offset:2048 lds
    buffer_load_dwordx4 v2, s[24:27], s41 offen offset:3072 lds
    s_add_u32 m0, s44, 65536
    s_mov_b32 s38, 65536
    buffer_load_dwordx4 v2, s[24:27], s37 offen offset:0 lds
    buffer_load_dwordx4 v2, s[24:27], s37 offen offset:1024 lds
    buffer_load_dwordx4 v2, s[24:27], s37 offen offset:2048 lds
    buffer_load_dwordx4 v2, s[24:27], s37 offen offset:3072 lds
    s_waitcnt vmcnt(8)
    v_readlane_b32 s8, v24, 0
    v_readlane_b32 s9, v24, 1
    v_and_b32 v3, 1, v1
    s_add_u32 s8, s8, 0x7f4a7c15
    s_addc_u32 s9, s9, 0x9e3779b9
    v_cmp_eq_u32 vcc, 1, v3
    v_mov_b32 v26, s8
    v_mov_b32 v27, s9
    v_cndmask_b32 v25, v26, v27, vcc
    s_cmp_lt_u32 s48, 6
    s_cbranch_scc1 L_i1
    s_lshl_b32 s40, s33, 3
    s_add_u32 s40, s40, s4
    s_mov_b64 exec, 1
    buffer_store_dwordx2 v[26:27], v23, s[12:15], s40 offen offset:8 sc1
    s_mov_b64 exec, -1
    s_cmp_ge_u32 s33, 2
    s_cbranch_scc1 L_i2
    v_dot2_f32_bf16 v3, v32, v32, 0
    v_dot2_f32_bf16 v8, v36, v36, 0
    v_dot2_f32_bf16 v4, v40, v40, 0
    v_dot2_f32_bf16 v9, v44, v44, 0
    v_dot2_f32_bf16 v3, v33, v33, v3
    v_dot2_f32_bf16 v8, v37, v37, v8
    v_dot2_f32_bf16 v4, v41, v41, v4
    v_dot2_f32_bf16 v9, v45, v45, v9
    v_dot2_f32_bf16 v3, v34, v34, v3
    v_dot2_f32_bf16 v8, v38, v38, v8
    v_dot2_f32_bf16 v4, v42, v42, v4
    v_dot2_f32_bf16 v9, v46, v46, v9
    v_dot2_f32_bf16 v3, v35, v35, v3
    v_dot2_f32_bf16 v8, v39, v39, v8
    v_dot2_f32_bf16 v4, v43, v43, v4
    v_dot2_f32_bf16 v9, v47, v47, v9
    v_mfma_f32_32x32x16_bf16 v[80:95], v[12:15], v[32:35], 0
    v_mfma_f32_32x32x16_bf16 v[80:95], v[16:19], v[36:39], v[80:95]
    v_mfma_f32_32x32x16_bf16 v[96:111], v[12:15], v[40:43], 0
    v_mfma_f32_32x32x16_bf16 v[96:111], v[16:19], v[44:47], v[96:111]
    v_add_f32 v3, v3, v4
    v_add_f32 v8, v8, v9
    v_add_f32 v3, v3, v8
    v_sqrt_f32 v3, v3
    s_nop 0
    v_add_f32 v3, 0x358637bd, v3
    v_rcp_f32 v6, v3
    s_nop 5
    v_pk_mul_f32 v[80:81], v[80:81], v[6:7] op_sel_hi:[1,0]
    v_pk_mul_f32 v[82:83], v[82:83], v[6:7] op_sel_hi:[1,0]
    v_pk_mul_f32 v[84:85], v[84:85], v[6:7] op_sel_hi:[1,0]
    v_pk_mul_f32 v[86:87], v[86:87], v[6:7] op_sel_hi:[1,0]
    v_pk_mul_f32 v[88:89], v[88:89], v[6:7] op_sel_hi:[1,0]
    v_pk_mul_f32 v[90:91], v[90:91], v[6:7] op_sel_hi:[1,0]
    v_pk_mul_f32 v[92:93], v[92:93], v[6:7] op_sel_hi:[1,0]
    v_pk_mul_f32 v[94:95], v[94:95], v[6:7] op_sel_hi:[1,0]
    v_pk_mul_f32 v[96:97], v[96:97], v[6:7] op_sel_hi:[1,0]
    v_pk_mul_f32 v[98:99], v[98:99], v[6:7] op_sel_hi:[1,0]
    v_pk_mul_f32 v[100:101], v[100:101], v[6:7] op_sel_hi:[1,0]
    v_pk_mul_f32 v[102:103], v[102:103], v[6:7] op_sel_hi:[1,0]
    v_pk_mul_f32 v[104:105], v[104:105], v[6:7] op_sel_hi:[1,0]
    v_pk_mul_f32 v[106:107], v[106:107], v[6:7] op_sel_hi:[1,0]
    v_pk_mul_f32 v[108:109], v[108:109], v[6:7] op_sel_hi:[1,0]
    v_pk_mul_f32 v[110:111], v[110:111], v[6:7] op_sel_hi:[1,0]
    v_cvt_pk_bf16_f32 v112, v80, v81
    v_cvt_pk_bf16_f32 v113, v82, v83
    v_cvt_pk_bf16_f32 v114, v84, v85
    v_cvt_pk_bf16_f32 v115, v86, v87
    v_cvt_pk_bf16_f32 v116, v88, v89
    v_cvt_pk_bf16_f32 v117, v90, v91
    v_cvt_pk_bf16_f32 v118, v92, v93
    v_cvt_pk_bf16_f32 v119, v94, v95
    v_cvt_pk_bf16_f32 v120, v96, v97
    v_cvt_pk_bf16_f32 v121, v98, v99
    v_cvt_pk_bf16_f32 v122, v100, v101
    v_cvt_pk_bf16_f32 v123, v102, v103
    v_cvt_pk_bf16_f32 v124, v104, v105
    v_cvt_pk_bf16_f32 v125, v106, v107
    v_cvt_pk_bf16_f32 v126, v108, v109
    v_cvt_pk_bf16_f32 v127, v110, v111
    ds_write_b128 v21, v[112:115] offset:32768
    ds_write_b128 v21, v[116:119] offset:33280
    ds_write_b128 v21, v[120:123] offset:33792
    ds_write_b128 v21, v[124:127] offset:34304
L_i2:
    s_waitcnt vmcnt(5) lgkmcnt(0)
    s_branch L_i3
L_i1:
    s_waitcnt vmcnt(4)
    s_cmp_lg_u32 s48, 0
    s_cbranch_scc1 L_i3
    buffer_load_dwordx4 v[64:67], v20, s[20:23], s50 offen offset:0
    buffer_load_dwordx4 v[68:71], v20, s[20:23], s50 offen offset:16
    buffer_load_dwordx4 v[72:75], v20, s[20:23], s50 offen offset:32
    buffer_load_dwordx4 v[76:79], v20, s[20:23], s50 offen offset:48
L_i3:
    s_barrier
L_ploop:
    s_waitcnt vmcnt(0)
    s_cmp_eq_u32 s49, 0
    s_cbranch_scc1 L_nopend
    s_lshl_b32 s40, s33, 3
    s_add_u32 s40, s40, s4
    s_mov_b64 exec, 1
    buffer_store_dwordx2 v[26:27], v23, s[12:15], s40 offen offset:8 sc1
    s_mov_b64 exec, -1
    s_mov_b32 s49, 0
L_nopend:
    s_mov_b32 s39, 8
L_poll:
    s_lshl_b32 s40, s35, 1
    s_bitcmp1_b32 s46, s40
    s_cbranch_scc1 L_ready
    s_cmp_eq_u32 s39, 0
    s_cbranch_scc1 L_local
    s_sub_u32 s39, s39, 1
    buffer_load_dword v24, v23, s[12:15], s4 offen sc1
    s_waitcnt vmcnt(0)
    v_cmp_eq_u32 vcc, v24, v25
    s_nop 0
    s_lshr_b32 s46, vcc_lo, 2
    s_lshr_b32 s40, vcc_lo, 3
    s_and_b32 s46, s46, s40
    s_branch L_poll
L_local:
    buffer_load_dwordx4 v[32:35], v20, s[20:23], s37 offen offset:0
    buffer_load_dwordx4 v[36:39], v20, s[20:23], s37 offen offset:16
    buffer_load_dwordx4 v[40:43], v20, s[20:23], s37 offen offset:32
    buffer_load_dwordx4 v[44:47], v20, s[20:23], s37 offen offset:48
    v_add_u32 v22, s38, v21
    s_waitcnt vmcnt(0)
    v_dot2_f32_bf16 v3, v32, v32, 0
    v_dot2_f32_bf16 v8, v36, v36, 0
    v_dot2_f32_bf16 v4, v40, v40, 0
    v_dot2_f32_bf16 v9, v44, v44, 0
    v_dot2_f32_bf16 v3, v33, v33, v3
    v_dot2_f32_bf16 v8, v37, v37, v8
    v_dot2_f32_bf16 v4, v41, v41, v4
    v_dot2_f32_bf16 v9, v45, v45, v9
    v_dot2_f32_bf16 v3, v34, v34, v3
    v_dot2_f32_bf16 v8, v38, v38, v8
    v_dot2_f32_bf16 v4, v42, v42, v4
    v_dot2_f32_bf16 v9, v46, v46, v9
    v_dot2_f32_bf16 v3, v35, v35, v3
    v_dot2_f32_bf16 v8, v39, v39, v8
    v_dot2_f32_bf16 v4, v43, v43, v4
    v_dot2_f32_bf16 v9, v47, v47, v9
    v_mfma_f32_32x32x16_bf16 v[80:95], v[12:15], v[32:35], 0
    v_mfma_f32_32x32x16_bf16 v[80:95], v[16:19], v[36:39], v[80:95]
    v_mfma_f32_32x32x16_bf16 v[96:111], v[12:15], v[40:43], 0
    v_mfma_f32_32x32x16_bf16 v[96:111], v[16:19], v[44:47], v[96:111]
    v_add_f32 v3, v3, v4
    v_add_f32 v8, v8, v9
    v_add_f32 v3, v3, v8
    v_sqrt_f32 v3, v3
    s_nop 0
    v_add_f32 v3, 0x358637bd, v3
    v_rcp_f32 v6, v3
    s_nop 5
    v_pk_mul_f32 v[80:81], v[80:81], v[6:7] op_sel_hi:[1,0]
    v_pk_mul_f32 v[82:83], v[82:83], v[6:7] op_sel_hi:[1,0]
    v_pk_mul_f32 v[84:85], v[84:85], v[6:7] op_sel_hi:[1,0]
    v_pk_mul_f32 v[86:87], v[86:87], v[6:7] op_sel_hi:[1,0]
    v_pk_mul_f32 v[88:89], v[88:89], v[6:7] op_sel_hi:[1,0]
    v_pk_mul_f32 v[90:91], v[90:91], v[6:7] op_sel_hi:[1,0]
    v_pk_mul_f32 v[92:93], v[92:93], v[6:7] op_sel_hi:[1,0]
    v_pk_mul_f32 v[94:95], v[94:95], v[6:7] op_sel_hi:[1,0]
    v_pk_mul_f32 v[96:97], v[96:97], v[6:7] op_sel_hi:[1,0]
    v_pk_mul_f32 v[98:99], v[98:99], v[6:7] op_sel_hi:[1,0]
    v_pk_mul_f32 v[100:101], v[100:101], v[6:7] op_sel_hi:[1,0]
    v_pk_mul_f32 v[102:103], v[102:103], v[6:7] op_sel_hi:[1,0]
    v_pk_mul_f32 v[104:105], v[104:105], v[6:7] op_sel_hi:[1,0]
    v_pk_mul_f32 v[106:107], v[106:107], v[6:7] op_sel_hi:[1,0]
    v_pk_mul_f32 v[108:109], v[108:109], v[6:7] op_sel_hi:[1,0]
    v_pk_mul_f32 v[110:111], v[110:111], v[6:7] op_sel_hi:[1,0]
    v_cvt_pk_bf16_f32 v112, v80, v81
    v_cvt_pk_bf16_f32 v113, v82, v83
    v_cvt_pk_bf16_f32 v114, v84, v85
    v_cvt_pk_bf16_f32 v115, v86, v87
    v_cvt_pk_bf16_f32 v116, v88, v89
    v_cvt_pk_bf16_f32 v117, v90, v91
    v_cvt_pk_bf16_f32 v118, v92, v93
    v_cvt_pk_bf16_f32 v119, v94, v95
    v_cvt_pk_bf16_f32 v120, v96, v97
    v_cvt_pk_bf16_f32 v121, v98, v99
    v_cvt_pk_bf16_f32 v122, v100, v101
    v_cvt_pk_bf16_f32 v123, v102, v103
    v_cvt_pk_bf16_f32 v124, v104, v105
    v_cvt_pk_bf16_f32 v125, v106, v107
    v_cvt_pk_bf16_f32 v126, v108, v109
    v_cvt_pk_bf16_f32 v127, v110, v111
    ds_write_b128 v22, v[112:115] offset:0
    ds_write_b128 v22, v[116:119] offset:512
    ds_write_b128 v22, v[120:123] offset:1024
    ds_write_b128 v22, v[124:127] offset:1536
    s_waitcnt lgkmcnt(0)
    s_branch L_have
L_ready:
    s_lshl_b32 s40, s35, 14
    s_add_u32 s40, s40, s47
    s_add_u32 m0, s42, s38
    s_nop 0
    buffer_load_dwordx4 v2, s[12:15], s40 offen offset:0 sc1 lds
    buffer_load_dwordx4 v2, s[12:15], s40 offen offset:1024 sc1 lds
    buffer_load_dwordx4 v2, s[12:15], s40 offen offset:2048 sc1 lds
    buffer_load_dwordx4 v2, s[12:15], s40 offen offset:3072 sc1 lds
L_have:
    s_cmp_eq_u32 s35, 5
    s_cbranch_scc1 L_plast
    s_add_u32 s38, s38, 32768
    s_and_b32 s38, s38, 0x1ffff
    s_add_u32 m0, s44, s38
    s_add_u32 s37, s35, 3
    s_lshl_b32 s37, s37, 14
    s_add_u32 s37, s37, s6
    s_and_b32 s37, s37, 0x1ffff
    s_add_u32 s37, s37, s32
    buffer_load_dwordx4 v2, s[24:27], s37 offen offset:0 lds
    buffer_load_dwordx4 v2, s[24:27], s37 offen offset:1024 lds
    buffer_load_dwordx4 v2, s[24:27], s37 offen offset:2048 lds
    buffer_load_dwordx4 v2, s[24:27], s37 offen offset:3072 lds
    s_cmp_eq_u32 s35, s48
    s_cbranch_scc1 L_pub
    s_add_u32 s35, s35, 1
    s_cmp_eq_u32 s35, s48
    s_cbranch_scc1 L_raw
    s_waitcnt vmcnt(4)
L_pbar:
    s_barrier
    s_branch L_ploop
L_pub:
    v_dot2_f32_bf16 v3, v64, v64, 0
    v_dot2_f32_bf16 v8, v68, v68, 0
    v_dot2_f32_bf16 v4, v72, v72, 0
    v_dot2_f32_bf16 v9, v76, v76, 0
    v_dot2_f32_bf16 v3, v65, v65, v3
    v_dot2_f32_bf16 v8, v69, v69, v8
    v_dot2_f32_bf16 v4, v73, v73, v4
    v_dot2_f32_bf16 v9, v77, v77, v9
    v_dot2_f32_bf16 v3, v66, v66, v3
    v_dot2_f32_bf16 v8, v70, v70, v8
    v_dot2_f32_bf16 v4, v74, v74, v4
    v_dot2_f32_bf16 v9, v78, v78, v9
    v_dot2_f32_bf16 v3, v67, v67, v3
    v_dot2_f32_bf16 v8, v71, v71, v8
    v_dot2_f32_bf16 v4, v75, v75, v4
    v_dot2_f32_bf16 v9, v79, v79, v9
    v_mfma_f32_32x32x16_bf16 v[80:95], v[12:15], v[64:67], 0
    v_mfma_f32_32x32x16_bf16 v[80:95], v[16:19], v[68:71], v[80:95]
    v_mfma_f32_32x32x16_bf16 v[96:111], v[12:15], v[72:75], 0
    v_mfma_f32_32x32x16_bf16 v[96:111], v[16:19], v[76:79], v[96:111]
    v_add_f32 v3, v3, v4
    v_add_f32 v8, v8, v9
    v_add_f32 v3, v3, v8
    v_sqrt_f32 v3, v3
    s_nop 0
    v_add_f32 v3, 0x358637bd, v3
    v_rcp_f32 v6, v3
    s_nop 5
    v_pk_mul_f32 v[80:81], v[80:81], v[6:7] op_sel_hi:[1,0]
    v_pk_mul_f32 v[82:83], v[82:83], v[6:7] op_sel_hi:[1,0]
    v_pk_mul_f32 v[84:85], v[84:85], v[6:7] op_sel_hi:[1,0]
    v_pk_mul_f32 v[86:87], v[86:87], v[6:7] op_sel_hi:[1,0]
    v_pk_mul_f32 v[88:89], v[88:89], v[6:7] op_sel_hi:[1,0]
    v_pk_mul_f32 v[90:91], v[90:91], v[6:7] op_sel_hi:[1,0]
    v_pk_mul_f32 v[92:93], v[92:93], v[6:7] op_sel_hi:[1,0]
    v_pk_mul_f32 v[94:95], v[94:95], v[6:7] op_sel_hi:[1,0]
    v_pk_mul_f32 v[96:97], v[96:97], v[6:7] op_sel_hi:[1,0]
    v_pk_mul_f32 v[98:99], v[98:99], v[6:7] op_sel_hi:[1,0]
    v_pk_mul_f32 v[100:101], v[100:101], v[6:7] op_sel_hi:[1,0]
    v_pk_mul_f32 v[102:103], v[102:103], v[6:7] op_sel_hi:[1,0]
    v_pk_mul_f32 v[104:105], v[104:105], v[6:7] op_sel_hi:[1,0]
    v_pk_mul_f32 v[106:107], v[106:107], v[6:7] op_sel_hi:[1,0]
    v_pk_mul_f32 v[108:109], v[108:109], v[6:7] op_sel_hi:[1,0]
    v_pk_mul_f32 v[110:111], v[110:111], v[6:7] op_sel_hi:[1,0]
    v_cvt_pk_bf16_f32 v112, v80, v81
    v_cvt_pk_bf16_f32 v113, v82, v83
    v_cvt_pk_bf16_f32 v114, v84, v85
    v_cvt_pk_bf16_f32 v115, v86, v87
    v_cvt_pk_bf16_f32 v116, v88, v89
    v_cvt_pk_bf16_f32 v117, v90, v91
    v_cvt_pk_bf16_f32 v118, v92, v93
    v_cvt_pk_bf16_f32 v119, v94, v95
    v_cvt_pk_bf16_f32 v120, v96, v97
    v_cvt_pk_bf16_f32 v121, v98, v99
    v_cvt_pk_bf16_f32 v122, v100, v101
    v_cvt_pk_bf16_f32 v123, v102, v103
    v_cvt_pk_bf16_f32 v124, v104, v105
    v_cvt_pk_bf16_f32 v125, v106, v107
    v_cvt_pk_bf16_f32 v126, v108, v109
    v_cvt_pk_bf16_f32 v127, v110, v111
    s_lshl_b32 s40, s33, 14
    s_add_u32 s40, s40, s47
    buffer_store_dwordx4 v[112:115], v28, s[12:15], s40 offen offset:0 sc1
    buffer_store_dwordx4 v[116:119], v28, s[12:15], s40 offen offset:512 sc1
    buffer_store_dwordx4 v[120:123], v28, s[12:15], s40 offen offset:1024 sc1
    buffer_store_dwordx4 v[124:127], v28, s[12:15], s40 offen offset:1536 sc1
    s_mov_b32 s49, 1
    s_add_u32 s35, s35, 1
    s_waitcnt vmcnt(8)
    s_branch L_pbar
L_raw:
    buffer_load_dwordx4 v[64:67], v20, s[20:23], s50 offen offset:0
    buffer_load_dwordx4 v[68:71], v20, s[20:23], s50 offen offset:16
    buffer_load_dwordx4 v[72:75], v20, s[20:23], s50 offen offset:32
    buffer_load_dwordx4 v[76:79], v20, s[20:23], s50 offen offset:48
    s_waitcnt vmcnt(8)
    s_branch L_pbar
L_plast:
    s_waitcnt vmcnt(0)
    s_barrier
    s_cmp_lg_u32 s33, 7
    s_cbranch_scc1 L_pend
L_fin:
    s_and_b32 s40, s46, 0x5555
    s_cmp_eq_u32 s40, 0x5555
    s_cbranch_scc1 L_bump
    buffer_load_dword v24, v23, s[12:15], s4 offen sc1
    s_waitcnt vmcnt(0)
    v_cmp_eq_u32 vcc, v24, v25
    s_nop 0
    s_lshr_b32 s46, vcc_lo, 2
    s_lshr_b32 s40, vcc_lo, 3
    s_and_b32 s46, s46, s40
    s_branch L_fin
L_bump:
    s_mov_b64 exec, 1
    buffer_store_dwordx2 v[26:27], v23, s[12:15], s4 offen sc1
    s_mov_b64 exec, -1
L_pend:
    s_endpgm
L_maxpass:
    ds_read_b128 v[44:47], v28
    ds_read_b128 v[48:51], v28 offset:1088
    s_mov_b32 s40, s32
    s_mov_b32 s41, 0
    v_mov_b32 v5, 0xff800000
    v_mov_b32 v8, 0xff800000
    s_waitcnt lgkmcnt(0)
L_maxloop:
    buffer_load_dwordx4 v[84:87], v27, s[20:23], s40 offen
    buffer_load_dwordx4 v[88:91], v27, s[20:23], s40 offen offset:32
    s_waitcnt vmcnt(0)
    v_mfma_f32_32x32x16_bf16 v[100:115], v[12:15], v[84:87], 0
    v_mfma_f32_32x32x16_bf16 v[100:115], v[16:19], v[88:91], v[100:115]
    v_dot2_f32_bf16 v3, v84, v84, 0
    v_dot2_f32_bf16 v4, v88, v88, 0
    v_dot2_f32_bf16 v3, v85, v85, v3
    v_dot2_f32_bf16 v4, v89, v89, v4
    v_dot2_f32_bf16 v3, v86, v86, v3
    v_dot2_f32_bf16 v4, v90, v90, v4
    v_dot2_f32_bf16 v3, v87, v87, v3
    v_dot2_f32_bf16 v4, v91, v91, v4
    s_nop 2
    v_add_f32 v3, v3, v4
    v_mov_b32 v4, v3
    s_nop 1
    v_permlane32_swap_b32 v3, v4
    s_nop 1
    v_add_f32 v3, v3, v4
    v_sqrt_f32 v3, v3
    s_nop 0
    v_add_f32 v3, 0x358637bd, v3
    v_rcp_f32 v6, v3
    s_nop 0
    v_pk_mul_f32 v[100:101], v[100:101], v[6:7] op_sel_hi:[1,0]
    v_pk_mul_f32 v[102:103], v[102:103], v[6:7] op_sel_hi:[1,0]
    v_pk_mul_f32 v[104:105], v[104:105], v[6:7] op_sel_hi:[1,0]
    v_pk_mul_f32 v[106:107], v[106:107], v[6:7] op_sel_hi:[1,0]
    v_pk_mul_f32 v[108:109], v[108:109], v[6:7] op_sel_hi:[1,0]
    v_pk_mul_f32 v[110:111], v[110:111], v[6:7] op_sel_hi:[1,0]
    v_pk_mul_f32 v[112:113], v[112:113], v[6:7] op_sel_hi:[1,0]
    v_pk_mul_f32 v[114:115], v[114:115], v[6:7] op_sel_hi:[1,0]
    v_cvt_pk_bf16_f32 v116, v100, v101
    v_cvt_pk_bf16_f32 v117, v102, v103
    v_cvt_pk_bf16_f32 v118, v104, v105
    v_cvt_pk_bf16_f32 v119, v106, v107
    v_cvt_pk_bf16_f32 v120, v108, v109
    v_cvt_pk_bf16_f32 v121, v110, v111
    v_cvt_pk_bf16_f32 v122, v112, v113
    v_cvt_pk_bf16_f32 v123, v114, v115
    s_nop 1
    v_mfma_f32_32x32x16_bf16 v[132:147], v[116:119], v[36:39], 0
    v_mfma_f32_32x32x16_bf16 v[132:147], v[120:123], v[40:43], v[132:147]
    v_mfma_f32_32x32x16_bf16 v[148:163], v[116:119], v[44:47], 0
    v_mfma_f32_32x32x16_bf16 v[148:163], v[120:123], v[48:51], v[148:163]
    s_nop 15
    v_max3_f32 v5, v132, v133, v5
    v_max3_f32 v5, v134, v135, v5
    v_max3_f32 v5, v136, v137, v5
    v_max3_f32 v5, v138, v139, v5
    v_max3_f32 v5, v140, v141, v5
    v_max3_f32 v5, v142, v143, v5
    v_max3_f32 v5, v144, v145, v5
    v_max3_f32 v5, v146, v147, v5
    v_max3_f32 v8, v148, v149, v8
    v_max3_f32 v8, v150, v151, v8
    v_max3_f32 v8, v152, v153, v8
    v_max3_f32 v8, v154, v155, v8
    v_max3_f32 v8, v156, v157, v8
    v_max3_f32 v8, v158, v159, v8
    v_max3_f32 v8, v160, v161, v8
    v_max3_f32 v8, v162, v163, v8
    s_add_u32 s40, s40, 2048
    s_add_u32 s41, s41, 1
    s_cmp_lt_u32 s41, 64
    s_cbranch_scc1 L_maxloop
    v_mov_b32 v3, v5
    s_nop 1
    v_permlane32_swap_b32 v3, v5
    s_nop 1
    v_max_f32 v5, v5, v3
    v_xor_b32 v132, 0x80000000, v5
    v_mov_b32 v133, v132
    v_mov_b32 v134, v132
    v_mov_b32 v135, v132
    v_mov_b32 v136, v132
    v_mov_b32 v137, v132
    v_mov_b32 v138, v132
    v_mov_b32 v139, v132
    v_mov_b32 v140, v132
    v_mov_b32 v141, v132
    v_mov_b32 v142, v132
    v_mov_b32 v143, v132
    v_mov_b32 v144, v132
    v_mov_b32 v145, v132
    v_mov_b32 v146, v132
    v_mov_b32 v147, v132
    v_mov_b32 v3, v8
    s_nop 1
    v_permlane32_swap_b32 v3, v8
    s_nop 1
    v_max_f32 v8, v8, v3
    v_xor_b32 v148, 0x80000000, v8
    v_mov_b32 v149, v148
    v_mov_b32 v150, v148
    v_mov_b32 v151, v148
    v_mov_b32 v152, v148
    v_mov_b32 v153, v148
    v_mov_b32 v154, v148
    v_mov_b32 v155, v148
    v_mov_b32 v156, v148
    v_mov_b32 v157, v148
    v_mov_b32 v158, v148
    v_mov_b32 v159, v148
    v_mov_b32 v160, v148
    v_mov_b32 v161, v148
    v_mov_b32 v162, v148
    v_mov_b32 v163, v148
    v_mov_b64 v[100:101], 0
    v_mov_b64 v[102:103], 0
    v_mov_b64 v[104:105], 0
    v_mov_b64 v[106:107], 0
    v_mov_b64 v[108:109], 0
    v_mov_b64 v[110:111], 0
    v_mov_b64 v[112:113], 0
    v_mov_b64 v[114:115], 0
    v_mov_b64 v[116:117], 0
    v_mov_b64 v[118:119], 0
    v_mov_b64 v[120:121], 0
    v_mov_b64 v[122:123], 0
    v_mov_b64 v[124:125], 0
    v_mov_b64 v[126:127], 0
    v_mov_b64 v[128:129], 0
    v_mov_b64 v[130:131], 0
    s_branch L_start
.section .rodata,"a"
.p2align 6
.amdhsa_kernel standalone__qk_norm__prompt_kernel
  .amdhsa_next_free_vgpr 168
  .amdhsa_next_free_sgpr 64
  .amdhsa_accum_offset 168
  .amdhsa_group_segment_fixed_size 0
  .amdhsa_kernarg_size 56
  .amdhsa_user_sgpr_count 2
  .amdhsa_user_sgpr_kernarg_segment_ptr 1
  .amdhsa_system_sgpr_workgroup_id_x 1
.end_amdhsa_kernel
```
